```python
import torch

def _softmax(x, axis=-1):
    return torch.softmax(x, dim=axis)
def _gelu(x):
    return torch.nn.functional.gelu(x, approximate="tanh")
def _silu(x):
    return torch.nn.functional.silu(x)
def _sigmoid(x):
    return torch.sigmoid(x)
def _layernorm(x, axis=-1, eps=1e-5):
    m = x.mean(dim=axis, keepdim=True)
    v = x.var(dim=axis, keepdim=True, unbiased=False)
    return (x - m) / torch.sqrt(v + eps)
def _scatter_add(tgt, idx, src, axis=0):
    return tgt.clone().index_add_(axis, idx, src)
def _segment_sum(src, seg, n):
    out = torch.zeros((n,) + src.shape[1:], dtype=src.dtype)
    return out.index_add_(0, seg, src)
def _pad(x, pw):
    flat = tuple(v for pair in reversed(pw) for v in pair)
    return torch.nn.functional.pad(x, flat)

kernel_name = 'standalone__rezero__sampling'

def setup_inputs():

    _w = (lambda a: (lambda t: t.to(torch.bfloat16) if t.is_floating_point() else t)(torch.as_tensor(a)))
    B, S, D = 1024, 32, 448
    return {
        "x": _w((lambda *s: torch.randn(*s, dtype=torch.bfloat16) * 0.05)(B, S, D)),
        "fx": _w((lambda *s: torch.randn(*s, dtype=torch.bfloat16) * 0.8)(B, S, D)),
        "alpha": _w((lambda *s: torch.randn(*s, dtype=torch.bfloat16) * 0.8)(1) * 0.1),
    }

def reference(x, fx, alpha):
    return x + alpha * fx
```

```asm
; @launch grid=(1792,1,1) block=(256,1,1) lds=0
.amdgcn_target "amdgcn-amd-amdhsa--gfx950"
.text
.globl standalone__rezero__sampling_kernel
.p2align 8
.type standalone__rezero__sampling_kernel,@function
standalone__rezero__sampling_kernel:
    s_load_dwordx8 s[4:11], s[0:1], 0
    s_cmp_ge_u32 s2, 1792
    s_cbranch_scc1 L_done
    s_mul_i32 s3, s2, 16384
    v_and_b32 v2, 63, v0
    v_lshrrev_b32 v3, 6, v0
    v_lshl_add_u32 v2, v2, 4, s3
    v_lshl_add_u32 v1, v3, 12, v2
    s_waitcnt lgkmcnt(0)
    s_load_dword s12, s[8:9], 0
    global_load_dwordx4 v[8:11], v1, s[4:5] offset:0 nt
    global_load_dwordx4 v[12:15], v1, s[6:7] offset:0 nt
    global_load_dwordx4 v[16:19], v1, s[4:5] offset:1024 nt
    global_load_dwordx4 v[20:23], v1, s[6:7] offset:1024 nt
    global_load_dwordx4 v[24:27], v1, s[4:5] offset:2048 nt
    global_load_dwordx4 v[28:31], v1, s[6:7] offset:2048 nt
    global_load_dwordx4 v[32:35], v1, s[4:5] offset:3072 nt
    global_load_dwordx4 v[36:39], v1, s[6:7] offset:3072 nt
    s_waitcnt lgkmcnt(0)
    s_lshl_b32 s12, s12, 16
    s_waitcnt vmcnt(6)
    v_lshlrev_b32 v4, 16, v12
    v_and_b32 v5, 0xffff0000, v12
    v_mul_f32 v4, s12, v4
    v_mul_f32 v5, s12, v5
    v_cvt_pk_bf16_f32 v12, v4, v5
    v_lshlrev_b32 v6, 16, v8
    v_and_b32 v7, 0xffff0000, v8
    v_lshlrev_b32 v4, 16, v12
    v_and_b32 v5, 0xffff0000, v12
    v_add_f32 v6, v6, v4
    v_add_f32 v7, v7, v5
    v_cvt_pk_bf16_f32 v8, v6, v7
    v_lshlrev_b32 v4, 16, v13
    v_and_b32 v5, 0xffff0000, v13
    v_mul_f32 v4, s12, v4
    v_mul_f32 v5, s12, v5
    v_cvt_pk_bf16_f32 v13, v4, v5
    v_lshlrev_b32 v6, 16, v9
    v_and_b32 v7, 0xffff0000, v9
    v_lshlrev_b32 v4, 16, v13
    v_and_b32 v5, 0xffff0000, v13
    v_add_f32 v6, v6, v4
    v_add_f32 v7, v7, v5
    v_cvt_pk_bf16_f32 v9, v6, v7
    v_lshlrev_b32 v4, 16, v14
    v_and_b32 v5, 0xffff0000, v14
    v_mul_f32 v4, s12, v4
    v_mul_f32 v5, s12, v5
    v_cvt_pk_bf16_f32 v14, v4, v5
    v_lshlrev_b32 v6, 16, v10
    v_and_b32 v7, 0xffff0000, v10
    v_lshlrev_b32 v4, 16, v14
    v_and_b32 v5, 0xffff0000, v14
    v_add_f32 v6, v6, v4
    v_add_f32 v7, v7, v5
    v_cvt_pk_bf16_f32 v10, v6, v7
    v_lshlrev_b32 v4, 16, v15
    v_and_b32 v5, 0xffff0000, v15
    v_mul_f32 v4, s12, v4
    v_mul_f32 v5, s12, v5
    v_cvt_pk_bf16_f32 v15, v4, v5
    v_lshlrev_b32 v6, 16, v11
    v_and_b32 v7, 0xffff0000, v11
    v_lshlrev_b32 v4, 16, v15
    v_and_b32 v5, 0xffff0000, v15
    v_add_f32 v6, v6, v4
    v_add_f32 v7, v7, v5
    v_cvt_pk_bf16_f32 v11, v6, v7
    global_store_dwordx4 v1, v[8:11], s[10:11] offset:0 sc1
    s_waitcnt vmcnt(5)
    v_lshlrev_b32 v4, 16, v20
    v_and_b32 v5, 0xffff0000, v20
    v_mul_f32 v4, s12, v4
    v_mul_f32 v5, s12, v5
    v_cvt_pk_bf16_f32 v20, v4, v5
    v_lshlrev_b32 v6, 16, v16
    v_and_b32 v7, 0xffff0000, v16
    v_lshlrev_b32 v4, 16, v20
    v_and_b32 v5, 0xffff0000, v20
    v_add_f32 v6, v6, v4
    v_add_f32 v7, v7, v5
    v_cvt_pk_bf16_f32 v16, v6, v7
    v_lshlrev_b32 v4, 16, v21
    v_and_b32 v5, 0xffff0000, v21
    v_mul_f32 v4, s12, v4
    v_mul_f32 v5, s12, v5
    v_cvt_pk_bf16_f32 v21, v4, v5
    v_lshlrev_b32 v6, 16, v17
    v_and_b32 v7, 0xffff0000, v17
    v_lshlrev_b32 v4, 16, v21
    v_and_b32 v5, 0xffff0000, v21
    v_add_f32 v6, v6, v4
    v_add_f32 v7, v7, v5
    v_cvt_pk_bf16_f32 v17, v6, v7
    v_lshlrev_b32 v4, 16, v22
    v_and_b32 v5, 0xffff0000, v22
    v_mul_f32 v4, s12, v4
    v_mul_f32 v5, s12, v5
    v_cvt_pk_bf16_f32 v22, v4, v5
    v_lshlrev_b32 v6, 16, v18
    v_and_b32 v7, 0xffff0000, v18
    v_lshlrev_b32 v4, 16, v22
    v_and_b32 v5, 0xffff0000, v22
    v_add_f32 v6, v6, v4
    v_add_f32 v7, v7, v5
    v_cvt_pk_bf16_f32 v18, v6, v7
    v_lshlrev_b32 v4, 16, v23
    v_and_b32 v5, 0xffff0000, v23
    v_mul_f32 v4, s12, v4
    v_mul_f32 v5, s12, v5
    v_cvt_pk_bf16_f32 v23, v4, v5
    v_lshlrev_b32 v6, 16, v19
    v_and_b32 v7, 0xffff0000, v19
    v_lshlrev_b32 v4, 16, v23
    v_and_b32 v5, 0xffff0000, v23
    v_add_f32 v6, v6, v4
    v_add_f32 v7, v7, v5
    v_cvt_pk_bf16_f32 v19, v6, v7
    global_store_dwordx4 v1, v[16:19], s[10:11] offset:1024 sc1
    s_waitcnt vmcnt(4)
    v_lshlrev_b32 v4, 16, v28
    v_and_b32 v5, 0xffff0000, v28
    v_mul_f32 v4, s12, v4
    v_mul_f32 v5, s12, v5
    v_cvt_pk_bf16_f32 v28, v4, v5
    v_lshlrev_b32 v6, 16, v24
    v_and_b32 v7, 0xffff0000, v24
    v_lshlrev_b32 v4, 16, v28
    v_and_b32 v5, 0xffff0000, v28
    v_add_f32 v6, v6, v4
    v_add_f32 v7, v7, v5
    v_cvt_pk_bf16_f32 v24, v6, v7
    v_lshlrev_b32 v4, 16, v29
    v_and_b32 v5, 0xffff0000, v29
    v_mul_f32 v4, s12, v4
    v_mul_f32 v5, s12, v5
    v_cvt_pk_bf16_f32 v29, v4, v5
    v_lshlrev_b32 v6, 16, v25
    v_and_b32 v7, 0xffff0000, v25
    v_lshlrev_b32 v4, 16, v29
    v_and_b32 v5, 0xffff0000, v29
    v_add_f32 v6, v6, v4
    v_add_f32 v7, v7, v5
    v_cvt_pk_bf16_f32 v25, v6, v7
    v_lshlrev_b32 v4, 16, v30
    v_and_b32 v5, 0xffff0000, v30
    v_mul_f32 v4, s12, v4
    v_mul_f32 v5, s12, v5
    v_cvt_pk_bf16_f32 v30, v4, v5
    v_lshlrev_b32 v6, 16, v26
    v_and_b32 v7, 0xffff0000, v26
    v_lshlrev_b32 v4, 16, v30
    v_and_b32 v5, 0xffff0000, v30
    v_add_f32 v6, v6, v4
    v_add_f32 v7, v7, v5
    v_cvt_pk_bf16_f32 v26, v6, v7
    v_lshlrev_b32 v4, 16, v31
    v_and_b32 v5, 0xffff0000, v31
    v_mul_f32 v4, s12, v4
    v_mul_f32 v5, s12, v5
    v_cvt_pk_bf16_f32 v31, v4, v5
    v_lshlrev_b32 v6, 16, v27
    v_and_b32 v7, 0xffff0000, v27
    v_lshlrev_b32 v4, 16, v31
    v_and_b32 v5, 0xffff0000, v31
    v_add_f32 v6, v6, v4
    v_add_f32 v7, v7, v5
    v_cvt_pk_bf16_f32 v27, v6, v7
    global_store_dwordx4 v1, v[24:27], s[10:11] offset:2048 sc1
    s_waitcnt vmcnt(3)
    v_lshlrev_b32 v4, 16, v36
    v_and_b32 v5, 0xffff0000, v36
    v_mul_f32 v4, s12, v4
    v_mul_f32 v5, s12, v5
    v_cvt_pk_bf16_f32 v36, v4, v5
    v_lshlrev_b32 v6, 16, v32
    v_and_b32 v7, 0xffff0000, v32
    v_lshlrev_b32 v4, 16, v36
    v_and_b32 v5, 0xffff0000, v36
    v_add_f32 v6, v6, v4
    v_add_f32 v7, v7, v5
    v_cvt_pk_bf16_f32 v32, v6, v7
    v_lshlrev_b32 v4, 16, v37
    v_and_b32 v5, 0xffff0000, v37
    v_mul_f32 v4, s12, v4
    v_mul_f32 v5, s12, v5
    v_cvt_pk_bf16_f32 v37, v4, v5
    v_lshlrev_b32 v6, 16, v33
    v_and_b32 v7, 0xffff0000, v33
    v_lshlrev_b32 v4, 16, v37
    v_and_b32 v5, 0xffff0000, v37
    v_add_f32 v6, v6, v4
    v_add_f32 v7, v7, v5
    v_cvt_pk_bf16_f32 v33, v6, v7
    v_lshlrev_b32 v4, 16, v38
    v_and_b32 v5, 0xffff0000, v38
    v_mul_f32 v4, s12, v4
    v_mul_f32 v5, s12, v5
    v_cvt_pk_bf16_f32 v38, v4, v5
    v_lshlrev_b32 v6, 16, v34
    v_and_b32 v7, 0xffff0000, v34
    v_lshlrev_b32 v4, 16, v38
    v_and_b32 v5, 0xffff0000, v38
    v_add_f32 v6, v6, v4
    v_add_f32 v7, v7, v5
    v_cvt_pk_bf16_f32 v34, v6, v7
    v_lshlrev_b32 v4, 16, v39
    v_and_b32 v5, 0xffff0000, v39
    v_mul_f32 v4, s12, v4
    v_mul_f32 v5, s12, v5
    v_cvt_pk_bf16_f32 v39, v4, v5
    v_lshlrev_b32 v6, 16, v35
    v_and_b32 v7, 0xffff0000, v35
    v_lshlrev_b32 v4, 16, v39
    v_and_b32 v5, 0xffff0000, v39
    v_add_f32 v6, v6, v4
    v_add_f32 v7, v7, v5
    v_cvt_pk_bf16_f32 v35, v6, v7
    global_store_dwordx4 v1, v[32:35], s[10:11] offset:3072 sc1
L_done:
    s_endpgm
.section .rodata,"a"
.p2align 6
.amdhsa_kernel standalone__rezero__sampling_kernel
  .amdhsa_next_free_vgpr 40
  .amdhsa_next_free_sgpr 24
  .amdhsa_accum_offset 40
  .amdhsa_group_segment_fixed_size 0
  .amdhsa_kernarg_size 48
  .amdhsa_user_sgpr_count 2
  .amdhsa_user_sgpr_kernarg_segment_ptr 1
  .amdhsa_system_sgpr_workgroup_id_x 1
  .amdhsa_float_denorm_mode_32 3
.end_amdhsa_kernel
```
